```python
import torch

def _softmax(x, axis=-1):
    return torch.softmax(x, dim=axis)
def _gelu(x):
    return torch.nn.functional.gelu(x, approximate="tanh")
def _silu(x):
    return torch.nn.functional.silu(x)
def _sigmoid(x):
    return torch.sigmoid(x)
def _layernorm(x, axis=-1, eps=1e-5):
    m = x.mean(dim=axis, keepdim=True)
    v = x.var(dim=axis, keepdim=True, unbiased=False)
    return (x - m) / torch.sqrt(v + eps)
def _scatter_add(tgt, idx, src, axis=0):
    return tgt.clone().index_add_(axis, idx, src)
def _segment_sum(src, seg, n):
    out = torch.zeros((n,) + src.shape[1:], dtype=src.dtype)
    return out.index_add_(0, seg, src)
def _pad(x, pw):
    flat = tuple(v for pair in reversed(pw) for v in pair)
    return torch.nn.functional.pad(x, flat)

kernel_name = 'standalone__deepnorm__sampling'

def setup_inputs():

    _w = (lambda a: (lambda t: t.to(torch.bfloat16) if t.is_floating_point() else t)(torch.as_tensor(a)))
    B, S, D = 1024, 8, 512
    return {
        "x": _w((lambda *s: torch.randn(*s, dtype=torch.bfloat16) * 0.05)(B, S, D)),
        "f": _w((lambda *s: torch.randn(*s, dtype=torch.bfloat16) * 0.05)(B, S, D)),
        "g": _w((lambda *s: torch.randn(*s, dtype=torch.bfloat16) * 0.05)(D) + 1.0),
        "b": _w((lambda *s: torch.randn(*s, dtype=torch.bfloat16) * 0.4)(D)),
        "alpha": _w(float(2.0)),
    }

def reference(x, f, g, b, alpha):
    return _layernorm(alpha * x + f, axis=-1) * g + b
```

```asm
; @launch grid=(512,1,1) block=(512,1,1) lds=0
.amdgcn_target "amdgcn-amd-amdhsa--gfx950"
.text
.globl standalone__deepnorm__sampling_kernel
.p2align 8
.type standalone__deepnorm__sampling_kernel,@function
standalone__deepnorm__sampling_kernel:
    s_load_dwordx16 s[4:19], s[0:1], 0
    s_cmpk_ge_u32 s2, 512
    s_cbranch_scc1 L_end
    s_bfe_u32 s3, s2, 0x20003
    s_and_b32 s23, s2, 7
    s_lshl_b32 s23, s23, 2
    s_or_b32 s3, s3, s23
    s_andn2_b32 s23, s2, 0x1f
    s_or_b32 s3, s3, s23
    s_lshl_b32 s3, s3, 13
    v_lshl_add_u32 v1, v0, 4, s3
    v_and_b32 v2, 0x3f0, v1
    s_waitcnt lgkmcnt(0)
    global_load_dwordx4 v[12:15], v1, s[4:5] nt
    global_load_dwordx4 v[16:19], v1, s[6:7] nt
    global_load_dwordx4 v[4:7], v2, s[8:9]
    global_load_dwordx4 v[8:11], v2, s[10:11]
    s_load_dword s20, s[12:13], 0
    v_add_u32 v60, 0x400000, v1
    s_mov_b32 s21, 0xffff0000
    s_mov_b32 s22, 0x3b000000
    v_mov_b32 v3, 0x3727c5ac
    s_waitcnt vmcnt(3)
    v_lshlrev_b32 v52, 16, v12
    v_and_b32 v53, s21, v12
    v_lshlrev_b32 v54, 16, v13
    v_and_b32 v55, s21, v13
    v_lshlrev_b32 v56, 16, v14
    v_and_b32 v57, s21, v14
    v_lshlrev_b32 v58, 16, v15
    v_and_b32 v59, s21, v15
    s_waitcnt vmcnt(2)
    global_load_dwordx4 v[20:23], v60, s[4:5] nt
    global_load_dwordx4 v[24:27], v60, s[6:7] nt
    s_waitcnt lgkmcnt(0)
    s_lshl_b32 s20, s20, 16
    v_lshlrev_b32 v44, 16, v16
    v_and_b32 v45, s21, v16
    v_pk_fma_f32 v[44:45], v[52:53], s[20:21], v[44:45] op_sel_hi:[1,0,1]
    v_lshlrev_b32 v46, 16, v17
    v_and_b32 v47, s21, v17
    v_pk_fma_f32 v[46:47], v[54:55], s[20:21], v[46:47] op_sel_hi:[1,0,1]
    v_lshlrev_b32 v48, 16, v18
    v_and_b32 v49, s21, v18
    v_pk_fma_f32 v[48:49], v[56:57], s[20:21], v[48:49] op_sel_hi:[1,0,1]
    v_lshlrev_b32 v50, 16, v19
    v_and_b32 v51, s21, v19
    v_pk_fma_f32 v[50:51], v[58:59], s[20:21], v[50:51] op_sel_hi:[1,0,1]
    v_pk_add_f32 v[12:13], v[44:45], v[46:47]
    v_pk_add_f32 v[14:15], v[48:49], v[50:51]
    v_pk_add_f32 v[12:13], v[12:13], v[14:15]
    v_add_f32 v12, v12, v13
    s_nop 1
    v_add_f32_dpp v12, v12, v12 quad_perm:[1,0,3,2] row_mask:0xf bank_mask:0xf
    s_nop 1
    v_add_f32_dpp v12, v12, v12 quad_perm:[2,3,0,1] row_mask:0xf bank_mask:0xf
    s_nop 1
    v_add_f32_dpp v12, v12, v12 row_half_mirror row_mask:0xf bank_mask:0xf
    s_nop 1
    v_add_f32_dpp v12, v12, v12 row_mirror row_mask:0xf bank_mask:0xf
    s_nop 1
    v_add_f32_dpp v12, v12, v12 row_bcast:15 row_mask:0xa bank_mask:0xf
    s_nop 1
    v_add_f32_dpp v12, v12, v12 row_bcast:31 row_mask:0xc bank_mask:0xf
    v_mul_f32 v12, s22, v12
    s_nop 0
    v_readlane_b32 s34, v12, 63
    s_nop 1
    v_pk_add_f32 v[44:45], v[44:45], s[34:35] op_sel_hi:[1,0] neg_lo:[0,1] neg_hi:[0,1]
    v_pk_add_f32 v[46:47], v[46:47], s[34:35] op_sel_hi:[1,0] neg_lo:[0,1] neg_hi:[0,1]
    v_pk_add_f32 v[48:49], v[48:49], s[34:35] op_sel_hi:[1,0] neg_lo:[0,1] neg_hi:[0,1]
    v_pk_add_f32 v[50:51], v[50:51], s[34:35] op_sel_hi:[1,0] neg_lo:[0,1] neg_hi:[0,1]
    v_pk_mul_f32 v[12:13], v[44:45], v[44:45]
    v_pk_fma_f32 v[12:13], v[46:47], v[46:47], v[12:13]
    v_pk_fma_f32 v[12:13], v[48:49], v[48:49], v[12:13]
    v_pk_fma_f32 v[12:13], v[50:51], v[50:51], v[12:13]
    v_add_f32 v12, v12, v13
    s_nop 1
    v_add_f32_dpp v12, v12, v12 quad_perm:[1,0,3,2] row_mask:0xf bank_mask:0xf
    s_nop 1
    v_add_f32_dpp v12, v12, v12 quad_perm:[2,3,0,1] row_mask:0xf bank_mask:0xf
    s_nop 1
    v_add_f32_dpp v12, v12, v12 row_half_mirror row_mask:0xf bank_mask:0xf
    s_nop 1
    v_add_f32_dpp v12, v12, v12 row_mirror row_mask:0xf bank_mask:0xf
    s_nop 1
    v_add_f32_dpp v12, v12, v12 row_bcast:15 row_mask:0xa bank_mask:0xf
    s_nop 1
    v_add_f32_dpp v12, v12, v12 row_bcast:31 row_mask:0xc bank_mask:0xf
    v_fma_f32 v12, v12, s22, v3
    v_rsq_f32 v12, v12
    s_waitcnt vmcnt(2)
    v_lshlrev_b32 v28, 16, v4
    v_and_b32 v29, s21, v4
    v_lshlrev_b32 v30, 16, v5
    v_and_b32 v31, s21, v5
    v_lshlrev_b32 v32, 16, v6
    v_and_b32 v33, s21, v6
    v_lshlrev_b32 v34, 16, v7
    v_and_b32 v35, s21, v7
    v_lshlrev_b32 v36, 16, v8
    v_and_b32 v37, s21, v8
    v_lshlrev_b32 v38, 16, v9
    v_and_b32 v39, s21, v9
    v_lshlrev_b32 v40, 16, v10
    v_and_b32 v41, s21, v10
    v_lshlrev_b32 v42, 16, v11
    v_and_b32 v43, s21, v11
    v_readlane_b32 s34, v12, 63
    v_pk_mul_f32 v[44:45], v[44:45], v[28:29]
    v_pk_mul_f32 v[46:47], v[46:47], v[30:31]
    v_pk_mul_f32 v[48:49], v[48:49], v[32:33]
    v_pk_mul_f32 v[50:51], v[50:51], v[34:35]
    v_pk_fma_f32 v[44:45], v[44:45], s[34:35], v[36:37] op_sel_hi:[1,0,1]
    v_pk_fma_f32 v[46:47], v[46:47], s[34:35], v[38:39] op_sel_hi:[1,0,1]
    v_pk_fma_f32 v[48:49], v[48:49], s[34:35], v[40:41] op_sel_hi:[1,0,1]
    v_pk_fma_f32 v[50:51], v[50:51], s[34:35], v[42:43] op_sel_hi:[1,0,1]
    v_cvt_pk_bf16_f32 v16, v44, v45
    v_cvt_pk_bf16_f32 v17, v46, v47
    v_cvt_pk_bf16_f32 v18, v48, v49
    v_cvt_pk_bf16_f32 v19, v50, v51
    s_waitcnt vmcnt(1)
    v_lshlrev_b32 v52, 16, v20
    v_and_b32 v53, s21, v20
    v_lshlrev_b32 v54, 16, v21
    v_and_b32 v55, s21, v21
    v_lshlrev_b32 v56, 16, v22
    v_and_b32 v57, s21, v22
    v_lshlrev_b32 v58, 16, v23
    v_and_b32 v59, s21, v23
    s_waitcnt vmcnt(0)
    global_store_dwordx4 v1, v[16:19], s[14:15]
    v_lshlrev_b32 v44, 16, v24
    v_and_b32 v45, s21, v24
    v_pk_fma_f32 v[44:45], v[52:53], s[20:21], v[44:45] op_sel_hi:[1,0,1]
    v_lshlrev_b32 v46, 16, v25
    v_and_b32 v47, s21, v25
    v_pk_fma_f32 v[46:47], v[54:55], s[20:21], v[46:47] op_sel_hi:[1,0,1]
    v_lshlrev_b32 v48, 16, v26
    v_and_b32 v49, s21, v26
    v_pk_fma_f32 v[48:49], v[56:57], s[20:21], v[48:49] op_sel_hi:[1,0,1]
    v_lshlrev_b32 v50, 16, v27
    v_and_b32 v51, s21, v27
    v_pk_fma_f32 v[50:51], v[58:59], s[20:21], v[50:51] op_sel_hi:[1,0,1]
    v_pk_add_f32 v[20:21], v[44:45], v[46:47]
    v_pk_add_f32 v[22:23], v[48:49], v[50:51]
    v_pk_add_f32 v[20:21], v[20:21], v[22:23]
    v_add_f32 v20, v20, v21
    s_nop 1
    v_add_f32_dpp v20, v20, v20 quad_perm:[1,0,3,2] row_mask:0xf bank_mask:0xf
    s_nop 1
    v_add_f32_dpp v20, v20, v20 quad_perm:[2,3,0,1] row_mask:0xf bank_mask:0xf
    s_nop 1
    v_add_f32_dpp v20, v20, v20 row_half_mirror row_mask:0xf bank_mask:0xf
    s_nop 1
    v_add_f32_dpp v20, v20, v20 row_mirror row_mask:0xf bank_mask:0xf
    s_nop 1
    v_add_f32_dpp v20, v20, v20 row_bcast:15 row_mask:0xa bank_mask:0xf
    s_nop 1
    v_add_f32_dpp v20, v20, v20 row_bcast:31 row_mask:0xc bank_mask:0xf
    v_mul_f32 v20, s22, v20
    s_nop 0
    v_readlane_b32 s34, v20, 63
    s_nop 1
    v_pk_add_f32 v[44:45], v[44:45], s[34:35] op_sel_hi:[1,0] neg_lo:[0,1] neg_hi:[0,1]
    v_pk_add_f32 v[46:47], v[46:47], s[34:35] op_sel_hi:[1,0] neg_lo:[0,1] neg_hi:[0,1]
    v_pk_add_f32 v[48:49], v[48:49], s[34:35] op_sel_hi:[1,0] neg_lo:[0,1] neg_hi:[0,1]
    v_pk_add_f32 v[50:51], v[50:51], s[34:35] op_sel_hi:[1,0] neg_lo:[0,1] neg_hi:[0,1]
    v_pk_mul_f32 v[20:21], v[44:45], v[44:45]
    v_pk_fma_f32 v[20:21], v[46:47], v[46:47], v[20:21]
    v_pk_fma_f32 v[20:21], v[48:49], v[48:49], v[20:21]
    v_pk_fma_f32 v[20:21], v[50:51], v[50:51], v[20:21]
    v_add_f32 v20, v20, v21
    v_pk_mul_f32 v[44:45], v[44:45], v[28:29]
    v_pk_mul_f32 v[46:47], v[46:47], v[30:31]
    v_add_f32_dpp v20, v20, v20 quad_perm:[1,0,3,2] row_mask:0xf bank_mask:0xf
    v_pk_mul_f32 v[48:49], v[48:49], v[32:33]
    v_pk_mul_f32 v[50:51], v[50:51], v[34:35]
    v_add_f32_dpp v20, v20, v20 quad_perm:[2,3,0,1] row_mask:0xf bank_mask:0xf
    s_nop 1
    v_add_f32_dpp v20, v20, v20 row_half_mirror row_mask:0xf bank_mask:0xf
    s_nop 1
    v_add_f32_dpp v20, v20, v20 row_mirror row_mask:0xf bank_mask:0xf
    s_nop 1
    v_add_f32_dpp v20, v20, v20 row_bcast:15 row_mask:0xa bank_mask:0xf
    s_nop 1
    v_add_f32_dpp v20, v20, v20 row_bcast:31 row_mask:0xc bank_mask:0xf
    v_fma_f32 v20, v20, s22, v3
    v_rsq_f32 v20, v20
    s_nop 0
    v_readlane_b32 s34, v20, 63
    s_nop 1
    v_pk_fma_f32 v[44:45], v[44:45], s[34:35], v[36:37] op_sel_hi:[1,0,1]
    v_pk_fma_f32 v[46:47], v[46:47], s[34:35], v[38:39] op_sel_hi:[1,0,1]
    v_pk_fma_f32 v[48:49], v[48:49], s[34:35], v[40:41] op_sel_hi:[1,0,1]
    v_pk_fma_f32 v[50:51], v[50:51], s[34:35], v[42:43] op_sel_hi:[1,0,1]
    v_cvt_pk_bf16_f32 v24, v44, v45
    v_cvt_pk_bf16_f32 v25, v46, v47
    v_cvt_pk_bf16_f32 v26, v48, v49
    v_cvt_pk_bf16_f32 v27, v50, v51
    global_store_dwordx4 v60, v[24:27], s[14:15]
L_end:
    s_endpgm
.section .rodata,"a"
.p2align 6
.amdhsa_kernel standalone__deepnorm__sampling_kernel
  .amdhsa_next_free_vgpr 61
  .amdhsa_next_free_sgpr 36
  .amdhsa_accum_offset 64
  .amdhsa_group_segment_fixed_size 0
  .amdhsa_kernarg_size 64
  .amdhsa_user_sgpr_count 2
  .amdhsa_user_sgpr_kernarg_segment_ptr 1
  .amdhsa_system_sgpr_workgroup_id_x 1
  .amdhsa_float_denorm_mode_32 3
.end_amdhsa_kernel
```
